```python
import torch

def _softmax(x, axis=-1):
    return torch.softmax(x, dim=axis)
def _gelu(x):
    return torch.nn.functional.gelu(x, approximate="tanh")
def _silu(x):
    return torch.nn.functional.silu(x)
def _sigmoid(x):
    return torch.sigmoid(x)
def _layernorm(x, axis=-1, eps=1e-5):
    m = x.mean(dim=axis, keepdim=True)
    v = x.var(dim=axis, keepdim=True, unbiased=False)
    return (x - m) / torch.sqrt(v + eps)
def _scatter_add(tgt, idx, src, axis=0):
    return tgt.clone().index_add_(axis, idx, src)
def _segment_sum(src, seg, n):
    out = torch.zeros((n,) + src.shape[1:], dtype=src.dtype)
    return out.index_add_(0, seg, src)
def _pad(x, pw):
    flat = tuple(v for pair in reversed(pw) for v in pair)
    return torch.nn.functional.pad(x, flat)

kernel_name = 'concat_heads__sliding_block_cached__sliding_block_cached__decode'

def setup_inputs():

    _w = (lambda a: (lambda t: t.to(torch.bfloat16) if t.is_floating_point() else t)(torch.as_tensor(a)))
    def _A_setup():
        B, Sq, D = 1, 1, 1024
        Hq, Hkv, Sk, Dh = 32, 4, 65536, 128
        assert Hq % Hkv == 0, (Hq, Hkv)
        return {
            "x": _w((lambda *s: torch.randn(*s, dtype=torch.bfloat16) * 1.6)(B, Sq, D)),
            "k_cache": _w((lambda *s: torch.randn(*s, dtype=torch.bfloat16) * 1.6)(B, Hkv, Sk, Dh)),
            "v_cache": _w((lambda *s: torch.randn(*s, dtype=torch.bfloat16) * 0.05)(B, Hkv, Sk, Dh)),
            "wq": _w((lambda *s: torch.randn(*s, dtype=torch.bfloat16) * 1.6)(D, Hq * Dh) * (D ** -0.5)),
            "wo": _w((lambda *s: torch.randn(*s, dtype=torch.bfloat16) * 0.05)(Hq * Dh, D) * ((Hq * Dh) ** -0.5)),
        }
    _A_in = _A_setup()

    def _B_setup():
        B, Sq, D = 1, 1, 1024
        Hq, Hkv, Sk, Dh = 32, 4, 65536, 128
        assert Hq % Hkv == 0, (Hq, Hkv)
        return {
            "x": _w((lambda *s: torch.randn(*s, dtype=torch.bfloat16) * 1.6)(B, Sq, D)),
            "k_cache": _w((lambda *s: torch.randn(*s, dtype=torch.bfloat16) * 1.6)(B, Hkv, Sk, Dh)),
            "v_cache": _w((lambda *s: torch.randn(*s, dtype=torch.bfloat16) * 0.05)(B, Hkv, Sk, Dh)),
            "wq": _w((lambda *s: torch.randn(*s, dtype=torch.bfloat16) * 1.6)(D, Hq * Dh) * (D ** -0.5)),
            "wo": _w((lambda *s: torch.randn(*s, dtype=torch.bfloat16) * 0.05)(Hq * Dh, D) * ((Hq * Dh) ** -0.5)),
        }
    _B_in = _B_setup()

    return {
        "A_x": _A_in["x"],
        "A_k_cache": _A_in["k_cache"],
        "A_v_cache": _A_in["v_cache"],
        "A_wq": _A_in["wq"],
        "A_wo": _A_in["wo"],
        "B_x": _B_in["x"],
        "B_k_cache": _B_in["k_cache"],
        "B_v_cache": _B_in["v_cache"],
        "B_wq": _B_in["wq"],
        "B_wo": _B_in["wo"],
    }

def reference(A_x, A_k_cache, A_v_cache, A_wq, A_wo, B_x, B_k_cache, B_v_cache, B_wq, B_wo):
    def _A_ref(x, k_cache, v_cache, wq, wo):
        B, Sq, D = x.shape
        Hq, Dh = 32, 128
        Hkv, Sk = k_cache.shape[1], k_cache.shape[2]
        W = min(4096, max(256, Sk // 4))
        rep = Hq // Hkv
        q = (lambda x, *d: x.permute(*d))((x @ wq).reshape(B, Sq, Hq, Dh), 0, 2, 1, 3)
        k = (lambda x, n, axis: torch.repeat_interleave(x, n, dim=axis))(k_cache[:, :, Sk - W:, :], rep, axis=1)
        v = (lambda x, n, axis: torch.repeat_interleave(x, n, dim=axis))(v_cache[:, :, Sk - W:, :], rep, axis=1)
        scores = torch.einsum("bhqd,bhkd->bhqk", q, k) * (Dh ** -0.5)
        p = _softmax(scores, axis=-1)
        o = torch.einsum("bhqk,bhkd->bhqd", p, v)
        return (lambda x, *d: x.permute(*d))(o, 0, 2, 1, 3).reshape(B, Sq, Hq * Dh) @ wo

    def _B_ref(x, k_cache, v_cache, wq, wo):
        B, Sq, D = x.shape
        Hq, Dh = 32, 128
        Hkv, Sk = k_cache.shape[1], k_cache.shape[2]
        W = min(4096, max(256, Sk // 4))
        rep = Hq // Hkv
        q = (lambda x, *d: x.permute(*d))((x @ wq).reshape(B, Sq, Hq, Dh), 0, 2, 1, 3)
        k = (lambda x, n, axis: torch.repeat_interleave(x, n, dim=axis))(k_cache[:, :, Sk - W:, :], rep, axis=1)
        v = (lambda x, n, axis: torch.repeat_interleave(x, n, dim=axis))(v_cache[:, :, Sk - W:, :], rep, axis=1)
        scores = torch.einsum("bhqd,bhkd->bhqk", q, k) * (Dh ** -0.5)
        p = _softmax(scores, axis=-1)
        o = torch.einsum("bhqk,bhkd->bhqd", p, v)
        return (lambda x, *d: x.permute(*d))(o, 0, 2, 1, 3).reshape(B, Sq, Hq * Dh) @ wo

    a = _A_ref(A_x, A_k_cache, A_v_cache, A_wq, A_wo)
    b = _B_ref(B_x, B_k_cache, B_v_cache, B_wq, B_wo)
    return torch.concatenate([a, b], axis=-1)
```

```asm
; @launch grid=(256,1,1) block=(320,1,1) lds=58464
.amdgcn_target "amdgcn-amd-amdhsa--gfx950"
.text
.p2align 12
.fill 320, 4, 0xbf810000
.globl concat_heads__sliding_block_cached__sliding_block_cached__decode_kernel
.p2align 8
.type concat_heads__sliding_block_cached__sliding_block_cached__decode_kernel,@function
concat_heads__sliding_block_cached__sliding_block_cached__decode_kernel:
    s_and_b32 s7, s2, 4
    s_mul_i32 s7, s7, 10
    s_add_u32 s8, s0, s7
    s_addc_u32 s9, s1, 0
    s_load_dwordx2 s[24:25], s[8:9], 24
    s_load_dwordx2 s[12:13], s[8:9], 0
    s_load_dwordx2 s[36:37], s[0:1], 96
    v_lshrrev_b32 v50, 6, v0
    v_bfe_u32 v2, v0, 4, 2
    v_readfirstlane_b32 s40, v50
    v_and_b32 v3, 15, v0
    s_cmpk_ge_u32 s2, 256
    s_cbranch_scc1 L_end
    v_lshlrev_b32 v5, 4, v3
    v_lshlrev_b32 v4, 7, v3
    v_lshl_add_u32 v5, v2, 13, v5
    v_lshl_add_u32 v4, v2, 1, v4
    s_bfe_u32 s5, s2, 0x10002
    s_cmp_eq_u32 s40, 4
    s_cbranch_scc1 L_helper
    s_mov_b32 s27, 0x20000
    s_mov_b32 s26, 0x800000
    s_movk_i32 s14, 2048
    s_mov_b32 s15, s27
    s_lshr_b32 s44, s2, 6
    s_lshl2_add_u32 s44, s44, s40
    s_and_b32 s45, s2, 3
    s_lshl4_add_u32 s45, s44, s45
    s_lshl_b32 s45, s45, 6
    s_and_b32 s60, s2, 56
    s_add_u32 s45, s45, s60
    s_lshl_b32 s45, s45, 5
    s_lshl_b32 s44, s44, 3
    s_waitcnt lgkmcnt(0)
    buffer_load_ushort v4, v4, s[12:15], s44 offen
    buffer_load_dwordx4 v[64:67], v5, s[24:27], s45 offen nt
    s_add_u32 s45, s45, 524288
    buffer_load_dwordx4 v[68:71], v5, s[24:27], s45 offen nt
    s_add_u32 s45, s45, 524288
    buffer_load_dwordx4 v[72:75], v5, s[24:27], s45 offen nt
    s_add_u32 s45, s45, 524288
    buffer_load_dwordx4 v[76:79], v5, s[24:27], s45 offen nt
    s_add_u32 s45, s45, 524288
    buffer_load_dwordx4 v[80:83], v5, s[24:27], s45 offen nt
    s_add_u32 s45, s45, 524288
    buffer_load_dwordx4 v[84:87], v5, s[24:27], s45 offen nt
    s_add_u32 s45, s45, 524288
    s_lshl_b32 s7, s5, 8
    s_load_dword s43, s[36:37], s7
    s_load_dwordx2 s[16:17], s[8:9], 8
    s_load_dwordx2 s[20:21], s[8:9], 16
    s_load_dwordx2 s[28:29], s[8:9], 32
    s_load_dwordx2 s[32:33], s[0:1], 80
    v_and_b32 v50, 1, v3
    v_lshlrev_b32 v50, 4, v50
    v_mov_b32 v51, 0xffff
    v_lshlrev_b32 v50, v50, v51
    v_lshrrev_b32 v51, 1, v3
    v_cmp_eq_u32 s[50:51], 0, v51
    v_cmp_eq_u32 s[52:53], 1, v51
    v_cmp_eq_u32 s[54:55], 2, v51
    v_cmp_eq_u32 s[56:57], 3, v51
    v_and_b32 v1, 63, v0
    s_and_b32 s3, s2, 7
    v_cndmask_b32 v6, 0, v50, s[50:51]
    v_cndmask_b32 v7, 0, v50, s[52:53]
    v_cndmask_b32 v8, 0, v50, s[54:55]
    v_cndmask_b32 v9, 0, v50, s[56:57]
    s_lshr_b32 s4, s2, 3
    s_and_b32 s6, s2, 3
    s_mov_b32 s38, 301993984
    s_mov_b32 s39, 0x20000
    s_movk_i32 s42, 1023
    s_mov_b32 s59, 8388608
    s_mov_b32 s18, 0x4000000
    s_mov_b32 s19, 0x20000
    s_mov_b32 s22, 0x4000000
    s_mov_b32 s23, 0x20000
    s_lshl_b32 s46, s6, 24
    s_lshl_b32 s61, s4, 10
    s_add_u32 s46, s46, s61
    s_lshl_b32 s61, s40, 15
    s_add_u32 s46, s46, s61
    s_add_u32 s46, s46, 15728640
    s_mov_b32 s47, s46
    s_lshl_b32 s58, s40, 10
    v_lshlrev_b32 v26, 4, v1
    v_lshlrev_b32 v50, 2, v2
    v_xor_b32 v50, v50, v3
    v_lshlrev_b32 v50, 4, v50
    v_lshl_add_u32 v22, v2, 8, v50
    v_xor_b32 v23, 16, v22
    v_xor_b32 v24, 32, v22
    v_xor_b32 v25, 48, v22
    v_and_b32 v50, 3, v3
    v_lshlrev_b32 v50, 4, v50
    v_lshrrev_b32 v51, 2, v3
    v_add_u32 v50, v50, v51
    v_lshlrev_b32 v50, 8, v50
    v_add_u32 v50, s58, v50
    v_xor_b32 v51, v2, v3
    v_lshl_add_u32 v28, v51, 4, v50
    v_xor_b32 v29, 64, v28
    v_xor_b32 v30, 0x80, v28
    v_xor_b32 v31, 0xc0, v28
    v_lshl_add_u32 v62, v3, 1, v2
    v_lshlrev_b32 v62, 4, v62
    s_lshl_b32 s60, s40, 10
    s_add_u32 s60, s60, 54272
    v_add_u32 v44, s60, v62
    s_lshl_b32 s60, s40, 9
    s_add_u32 s60, s60, 32768
    v_add_u32 v62, s60, v62
    s_lshl_b32 s60, s40, 7
    s_add_u32 s60, s60, 32768
    v_add_u32 v63, s60, v26
    s_lshl_b32 s60, s40, 8
    s_add_u32 s60, s60, 54272
    v_add_u32 v61, s60, v26
    s_lshl_b32 s50, s3, 14
    s_add_u32 s50, s50, 32768
    s_and_b32 s60, s4, 7
    s_lshl_b32 s60, s60, 11
    s_add_u32 s49, s50, s60
    s_lshr_b32 s60, s4, 3
    s_lshl2_add_u32 s60, s60, s40
    s_lshl_b32 s60, s60, 7
    s_add_u32 s49, s49, s60
    s_lshl_b32 s60, s40, 12
    s_add_u32 s50, s50, s60
    s_waitcnt vmcnt(6)
    v_lshl_or_b32 v4, v4, 16, v4
    s_nop 1
    v_and_b32_dpp v10, v4, v6 row_newbcast:0 row_mask:0xf bank_mask:0xf
    v_and_b32_dpp v11, v4, v7 row_newbcast:0 row_mask:0xf bank_mask:0xf
    v_and_b32_dpp v12, v4, v8 row_newbcast:0 row_mask:0xf bank_mask:0xf
    v_and_b32_dpp v13, v4, v9 row_newbcast:0 row_mask:0xf bank_mask:0xf
    s_waitcnt vmcnt(5)
    s_nop 0
    v_mfma_f32_16x16x32_bf16 v[18:21], v[10:13], v[64:67], 0
    buffer_load_dwordx4 v[88:91], v5, s[24:27], s45 offen nt
    s_add_u32 s45, s45, 524288
    v_lshrrev_b32 v52, 5, v1
    v_and_b32 v53, 31, v1
    v_lshlrev_b32 v54, 4, v53
    s_lshl_b32 s60, s40, 1
    v_add_u32 v55, s60, v52
    v_and_b32 v56, 7, v3
    v_lshl_add_u32 v45, v52, 11, v54
    v_mul_u32_u24 v34, 288, v55
    v_lshl_add_u32 v34, v53, 3, v34
    v_add_u32 v34, 34816, v34
    v_mul_u32_u24 v35, 288, v56
    v_lshl_add_u32 v35, v2, 4, v35
    v_add_u32 v35, 34816, v35
    v_mul_u32_u24 v37, 528, v55
    v_add_u32 v37, v37, v54
    v_add_u32 v37, 37120, v37
    v_lshlrev_b32 v39, 5, v55
    v_add_u32 v39, 54016, v39
    v_lshlrev_b32 v40, 3, v53
    v_lshl_add_u32 v40, v52, 13, v40
    v_lshlrev_b32 v41, 8, v52
    v_and_b32_dpp v14, v4, v6 row_newbcast:1 row_mask:0xf bank_mask:0xf
    v_and_b32_dpp v15, v4, v7 row_newbcast:1 row_mask:0xf bank_mask:0xf
    v_and_b32_dpp v16, v4, v8 row_newbcast:1 row_mask:0xf bank_mask:0xf
    v_and_b32_dpp v17, v4, v9 row_newbcast:1 row_mask:0xf bank_mask:0xf
    s_waitcnt vmcnt(5)
    s_nop 0
    v_mfma_f32_16x16x32_bf16 v[18:21], v[14:17], v[68:71], v[18:21]
    buffer_load_dwordx4 v[92:95], v5, s[24:27], s45 offen nt
    s_add_u32 s45, s45, 524288
    v_mul_u32_u24 v36, 528, v56
    v_lshl_add_u32 v36, v2, 5, v36
    v_lshrrev_b32 v57, 3, v3
    v_lshl_add_u32 v36, v57, 4, v36
    s_mul_i32 s60, s40, 4224
    s_add_u32 s60, s60, 37120
    v_add_u32 v36, s60, v36
    s_lshl_b32 s60, s40, 3
    s_add_u32 s60, s60, 54016
    v_lshlrev_b32 v38, 5, v56
    v_add_u32 v38, s60, v38
    v_lshrrev_b32 v59, 2, v1
    v_and_b32 v50, 3, v1
    v_lshlrev_b32 v42, 4, v50
    v_lshl_add_u32 v42, v59, 8, v42
    v_lshlrev_b32 v43, 4, v59
    v_and_b32 v58, 1, v1
    v_lshrrev_b32 v48, 1, v1
    v_lshlrev_b32 v48, 10, v48
    v_lshl_add_u32 v48, v58, 4, v48
    v_lshl_add_u32 v46, v3, 2, v2
    v_lshlrev_b32 v46, 1, v46
    v_and_b32_dpp v10, v4, v6 row_newbcast:2 row_mask:0xf bank_mask:0xf
    v_and_b32_dpp v11, v4, v7 row_newbcast:2 row_mask:0xf bank_mask:0xf
    v_and_b32_dpp v12, v4, v8 row_newbcast:2 row_mask:0xf bank_mask:0xf
    v_and_b32_dpp v13, v4, v9 row_newbcast:2 row_mask:0xf bank_mask:0xf
    s_waitcnt vmcnt(5)
    s_nop 0
    v_mfma_f32_16x16x32_bf16 v[18:21], v[10:13], v[72:75], v[18:21]
    buffer_load_dwordx4 v[96:99], v5, s[24:27], s45 offen nt
    s_add_u32 s45, s45, 524288
    s_mov_b32 s30, 0x800000
    s_mov_b32 s31, 0x20000
    s_movk_i32 s34, 4096
    s_mov_b32 s35, 0x20000
    s_lshl_b32 s48, s6, 21
    s_lshr_b32 s61, s4, 2
    s_lshl_b32 s61, s61, 18
    s_add_u32 s48, s48, s61
    s_and_b32 s61, s4, 3
    s_lshl_b32 s61, s61, 9
    s_add_u32 s48, s48, s61
    s_lshl_b32 s61, s40, 11
    s_add_u32 s48, s48, s61
    v_lshlrev_b32 v27, 4, v3
    v_lshl_add_u32 v27, v2, 14, v27
    v_and_b32_dpp v14, v4, v6 row_newbcast:3 row_mask:0xf bank_mask:0xf
    v_and_b32_dpp v15, v4, v7 row_newbcast:3 row_mask:0xf bank_mask:0xf
    v_and_b32_dpp v16, v4, v8 row_newbcast:3 row_mask:0xf bank_mask:0xf
    v_and_b32_dpp v17, v4, v9 row_newbcast:3 row_mask:0xf bank_mask:0xf
    s_waitcnt vmcnt(5)
    s_nop 0
    v_mfma_f32_16x16x32_bf16 v[18:21], v[14:17], v[76:79], v[18:21]
    buffer_load_dwordx4 v[100:103], v5, s[24:27], s45 offen nt
    s_add_u32 s45, s45, 524288
    s_lshl_b32 s51, s3, 16
    s_lshl_b32 s60, s40, 14
    s_add_u32 s51, s51, s60
    s_lshl_b32 s60, s4, 8
    s_add_u32 s51, s51, s60
    s_add_u32 s51, s51, 524288
    s_lshl_b32 s52, s3, 11
    s_lshl_b32 s60, s40, 9
    s_add_u32 s52, s52, s60
    s_and_b32 s60, s4, 15
    s_lshl4_add_u32 s52, s60, s52
    s_lshr_b32 s60, s4, 4
    s_lshl3_add_u32 s52, s60, s52
    s_add_u32 s52, s52, 196608
    s_lshr_b32 s61, s4, 2
    s_lshl3_add_u32 s61, s3, s61
    s_lshl_b32 s53, s61, 13
    s_lshl_b32 s60, s40, 6
    s_add_u32 s53, s53, s60
    s_add_u32 s53, s53, 524288
    s_add_u32 s66, s53, 4096
    s_lshl_b32 s54, s61, 8
    s_add_u32 s54, s54, 196608
    v_and_b32_dpp v10, v4, v6 row_newbcast:4 row_mask:0xf bank_mask:0xf
    v_and_b32_dpp v11, v4, v7 row_newbcast:4 row_mask:0xf bank_mask:0xf
    v_and_b32_dpp v12, v4, v8 row_newbcast:4 row_mask:0xf bank_mask:0xf
    v_and_b32_dpp v13, v4, v9 row_newbcast:4 row_mask:0xf bank_mask:0xf
    s_waitcnt vmcnt(5)
    s_nop 0
    v_mfma_f32_16x16x32_bf16 v[18:21], v[10:13], v[80:83], v[18:21]
    buffer_load_dwordx4 v[104:107], v5, s[24:27], s45 offen nt
    s_add_u32 s45, s45, 524288
    s_and_b32 s60, s4, 3
    s_lshl2_add_u32 s55, s5, s60
    s_lshl_b32 s55, s55, 5
    s_lshl3_add_u32 s55, s6, s55
    s_lshr_b32 s60, s4, 2
    s_add_u32 s55, s55, s60
    s_lshl2_add_u32 s55, s55, s40
    s_lshl_b32 s55, s55, 8
    s_add_u32 s55, s55, 262144
    s_lshl_b32 s56, s3, 15
    s_lshl_b32 s60, s4, 5
    s_add_u32 s56, s56, s60
    s_add_u32 s56, s56, 262144
    s_lshl_b32 s57, s3, 9
    s_lshl4_add_u32 s57, s4, s57
    s_mov_b32 s62, 0x05040100
    s_mov_b32 s63, 0x07060302
    s_mov_b32 s64, 0x00ff00ff
    s_mov_b32 s65, 0x00ff00ff
    v_and_b32_dpp v14, v4, v6 row_newbcast:5 row_mask:0xf bank_mask:0xf
    v_and_b32_dpp v15, v4, v7 row_newbcast:5 row_mask:0xf bank_mask:0xf
    v_and_b32_dpp v16, v4, v8 row_newbcast:5 row_mask:0xf bank_mask:0xf
    v_and_b32_dpp v17, v4, v9 row_newbcast:5 row_mask:0xf bank_mask:0xf
    s_waitcnt vmcnt(5)
    s_nop 0
    v_mfma_f32_16x16x32_bf16 v[18:21], v[14:17], v[84:87], v[18:21]
    buffer_load_dwordx4 v[108:111], v5, s[24:27], s45 offen nt
    s_add_u32 s45, s45, 524288
    s_waitcnt lgkmcnt(0)
    s_add_u32 s43, s43, 1
    s_and_b32 s41, s43, s42
    v_mov_b32 v32, s41
    v_mov_b32 v47, 0x3f803f80
    v_and_b32_dpp v10, v4, v6 row_newbcast:6 row_mask:0xf bank_mask:0xf
    v_and_b32_dpp v11, v4, v7 row_newbcast:6 row_mask:0xf bank_mask:0xf
    v_and_b32_dpp v12, v4, v8 row_newbcast:6 row_mask:0xf bank_mask:0xf
    v_and_b32_dpp v13, v4, v9 row_newbcast:6 row_mask:0xf bank_mask:0xf
    s_waitcnt vmcnt(5)
    s_nop 0
    v_mfma_f32_16x16x32_bf16 v[18:21], v[10:13], v[88:91], v[18:21]
    buffer_load_dwordx4 v[112:115], v5, s[24:27], s45 offen nt
    s_add_u32 s45, s45, 524288
    v_and_b32_dpp v14, v4, v6 row_newbcast:7 row_mask:0xf bank_mask:0xf
    v_and_b32_dpp v15, v4, v7 row_newbcast:7 row_mask:0xf bank_mask:0xf
    v_and_b32_dpp v16, v4, v8 row_newbcast:7 row_mask:0xf bank_mask:0xf
    v_and_b32_dpp v17, v4, v9 row_newbcast:7 row_mask:0xf bank_mask:0xf
    s_waitcnt vmcnt(5)
    s_nop 0
    v_mfma_f32_16x16x32_bf16 v[18:21], v[14:17], v[92:95], v[18:21]
    buffer_load_dwordx4 v[116:119], v5, s[24:27], s45 offen nt
    s_add_u32 s45, s45, 524288
    v_and_b32_dpp v10, v4, v6 row_newbcast:8 row_mask:0xf bank_mask:0xf
    v_and_b32_dpp v11, v4, v7 row_newbcast:8 row_mask:0xf bank_mask:0xf
    v_and_b32_dpp v12, v4, v8 row_newbcast:8 row_mask:0xf bank_mask:0xf
    v_and_b32_dpp v13, v4, v9 row_newbcast:8 row_mask:0xf bank_mask:0xf
    s_waitcnt vmcnt(5)
    s_nop 0
    v_mfma_f32_16x16x32_bf16 v[18:21], v[10:13], v[96:99], v[18:21]
    buffer_load_dwordx4 v[120:123], v5, s[24:27], s45 offen nt
    s_add_u32 s45, s45, 524288
    v_and_b32_dpp v14, v4, v6 row_newbcast:9 row_mask:0xf bank_mask:0xf
    v_and_b32_dpp v15, v4, v7 row_newbcast:9 row_mask:0xf bank_mask:0xf
    v_and_b32_dpp v16, v4, v8 row_newbcast:9 row_mask:0xf bank_mask:0xf
    v_and_b32_dpp v17, v4, v9 row_newbcast:9 row_mask:0xf bank_mask:0xf
    s_waitcnt vmcnt(5)
    s_nop 0
    v_mfma_f32_16x16x32_bf16 v[18:21], v[14:17], v[100:103], v[18:21]
    buffer_load_dwordx4 v[124:127], v5, s[24:27], s45 offen nt
    v_and_b32_dpp v10, v4, v6 row_newbcast:10 row_mask:0xf bank_mask:0xf
    v_and_b32_dpp v11, v4, v7 row_newbcast:10 row_mask:0xf bank_mask:0xf
    v_and_b32_dpp v12, v4, v8 row_newbcast:10 row_mask:0xf bank_mask:0xf
    v_and_b32_dpp v13, v4, v9 row_newbcast:10 row_mask:0xf bank_mask:0xf
    s_waitcnt vmcnt(5)
    s_nop 0
    v_mfma_f32_16x16x32_bf16 v[18:21], v[10:13], v[104:107], v[18:21]
    s_mov_b32 m0, s58
    s_add_u32 s58, s58, 4096
    buffer_load_dwordx4 v22, s[16:19], s46 offen nt lds
    s_add_u32 s46, s46, 131072
    v_and_b32_dpp v14, v4, v6 row_newbcast:11 row_mask:0xf bank_mask:0xf
    v_and_b32_dpp v15, v4, v7 row_newbcast:11 row_mask:0xf bank_mask:0xf
    v_and_b32_dpp v16, v4, v8 row_newbcast:11 row_mask:0xf bank_mask:0xf
    v_and_b32_dpp v17, v4, v9 row_newbcast:11 row_mask:0xf bank_mask:0xf
    s_waitcnt vmcnt(5)
    s_nop 0
    v_mfma_f32_16x16x32_bf16 v[18:21], v[14:17], v[108:111], v[18:21]
    s_mov_b32 m0, s58
    s_add_u32 s58, s58, 4096
    buffer_load_dwordx4 v23, s[16:19], s46 offen nt lds
    s_add_u32 s46, s46, 131072
    v_and_b32_dpp v10, v4, v6 row_newbcast:12 row_mask:0xf bank_mask:0xf
    v_and_b32_dpp v11, v4, v7 row_newbcast:12 row_mask:0xf bank_mask:0xf
    v_and_b32_dpp v12, v4, v8 row_newbcast:12 row_mask:0xf bank_mask:0xf
    v_and_b32_dpp v13, v4, v9 row_newbcast:12 row_mask:0xf bank_mask:0xf
    s_waitcnt vmcnt(5)
    s_nop 0
    v_mfma_f32_16x16x32_bf16 v[18:21], v[10:13], v[112:115], v[18:21]
    s_mov_b32 m0, s58
    s_add_u32 s58, s58, 4096
    buffer_load_dwordx4 v24, s[16:19], s46 offen nt lds
    s_add_u32 s46, s46, 131072
    v_and_b32_dpp v14, v4, v6 row_newbcast:13 row_mask:0xf bank_mask:0xf
    v_and_b32_dpp v15, v4, v7 row_newbcast:13 row_mask:0xf bank_mask:0xf
    v_and_b32_dpp v16, v4, v8 row_newbcast:13 row_mask:0xf bank_mask:0xf
    v_and_b32_dpp v17, v4, v9 row_newbcast:13 row_mask:0xf bank_mask:0xf
    s_waitcnt vmcnt(5)
    s_nop 0
    v_mfma_f32_16x16x32_bf16 v[18:21], v[14:17], v[116:119], v[18:21]
    s_mov_b32 m0, s58
    s_add_u32 s58, s58, 4096
    buffer_load_dwordx4 v25, s[16:19], s46 offen nt lds
    s_add_u32 s46, s46, 131072
    v_and_b32_dpp v10, v4, v6 row_newbcast:14 row_mask:0xf bank_mask:0xf
    v_and_b32_dpp v11, v4, v7 row_newbcast:14 row_mask:0xf bank_mask:0xf
    v_and_b32_dpp v12, v4, v8 row_newbcast:14 row_mask:0xf bank_mask:0xf
    v_and_b32_dpp v13, v4, v9 row_newbcast:14 row_mask:0xf bank_mask:0xf
    s_waitcnt vmcnt(5)
    s_nop 0
    v_mfma_f32_16x16x32_bf16 v[18:21], v[10:13], v[120:123], v[18:21]
    s_mov_b32 m0, s58
    s_add_u32 s58, s58, 4096
    buffer_load_dwordx4 v22, s[16:19], s46 offen nt lds
    s_add_u32 s46, s46, 131072
    v_and_b32_dpp v14, v4, v6 row_newbcast:15 row_mask:0xf bank_mask:0xf
    v_and_b32_dpp v15, v4, v7 row_newbcast:15 row_mask:0xf bank_mask:0xf
    v_and_b32_dpp v16, v4, v8 row_newbcast:15 row_mask:0xf bank_mask:0xf
    v_and_b32_dpp v17, v4, v9 row_newbcast:15 row_mask:0xf bank_mask:0xf
    s_waitcnt vmcnt(5)
    s_nop 0
    v_mfma_f32_16x16x32_bf16 v[18:21], v[14:17], v[124:127], v[18:21]
    s_mov_b32 m0, s58
    s_add_u32 s58, s58, 4096
    buffer_load_dwordx4 v23, s[16:19], s46 offen nt lds
    s_add_u32 s46, s46, 131072
    v_mov_b32 v53, 58368
    s_mov_b32 exec_hi, 0
    s_nop 1
    ds_write_b128 v62, v[18:21]
    s_mov_b64 exec, 0xff
    s_waitcnt lgkmcnt(0)
    s_barrier
    ds_read_b32 v52, v53
    ds_read_b128 v[224:227], v63 offset:0
    ds_read_b128 v[228:231], v63 offset:512
    ds_read_b128 v[232:235], v63 offset:1024
    ds_read_b128 v[236:239], v63 offset:1536
    s_waitcnt lgkmcnt(0)
    v_readfirstlane_b32 s69, v52
    v_pk_add_f32 v[224:225], v[224:225], v[228:229]
    v_pk_add_f32 v[232:233], v[232:233], v[236:237]
    v_pk_add_f32 v[226:227], v[226:227], v[230:231]
    v_pk_add_f32 v[234:235], v[234:235], v[238:239]
    v_pk_add_f32 v[224:225], v[224:225], v[232:233]
    v_pk_add_f32 v[226:227], v[226:227], v[234:235]
    v_bfi_b32 v224, s42, v32, v224
    v_bfi_b32 v225, s42, v32, v225
    v_bfi_b32 v226, s42, v32, v226
    v_bfi_b32 v227, s42, v32, v227
    s_cmp_eq_u32 s69, 0
    s_cbranch_scc0 L_glob1
    buffer_store_dwordx4 v[224:227], v26, s[36:39], s49 offen
L_st1:
    s_mov_b64 exec, -1
    v_mov_b32 v18, v47
    v_mov_b32 v19, v47
    v_mov_b32 v20, v47
    v_mov_b32 v21, v47
    v_mov_b32 v10, 0
    v_mov_b32 v11, 0
    v_mov_b32 v12, 0
    v_mov_b32 v13, 0
    v_mov_b32 v14, 0
    v_mov_b32 v15, 0
    v_mov_b32 v16, 0
    v_mov_b32 v17, 0
    s_waitcnt vmcnt(6)
    s_mov_b32 m0, s58
    s_add_u32 s58, s58, 4096
    buffer_load_dwordx4 v24, s[16:19], s46 offen nt lds
    s_add_u32 s46, s46, 131072
    s_waitcnt vmcnt(6)
    s_mov_b32 m0, s58
    s_nop 0
    buffer_load_dwordx4 v25, s[16:19], s46 offen nt lds
    s_waitcnt vmcnt(6)
    buffer_load_dwordx4 v[160:163], v26, s[20:23], s47 offen nt
    s_add_u32 s47, s47, 131072
    s_waitcnt vmcnt(6)
    buffer_load_dwordx4 v[164:167], v26, s[20:23], s47 offen nt
    s_add_u32 s47, s47, 131072
    s_waitcnt vmcnt(6)
    buffer_load_dwordx4 v[168:171], v26, s[20:23], s47 offen nt
    s_add_u32 s47, s47, 131072
    s_waitcnt vmcnt(6)
    buffer_load_dwordx4 v[172:175], v26, s[20:23], s47 offen nt
    s_add_u32 s47, s47, 131072
    buffer_load_dwordx4 v[224:227], v45, s[36:39], s50 offen offset:0 sc1
    buffer_load_dwordx4 v[228:231], v45, s[36:39], s50 offen offset:512 sc1
    buffer_load_dwordx4 v[232:235], v45, s[36:39], s50 offen offset:1024 sc1
    buffer_load_dwordx4 v[236:239], v45, s[36:39], s50 offen offset:1536 sc1
    s_waitcnt vmcnt(9)
    buffer_load_dwordx4 v[176:179], v26, s[20:23], s47 offen nt
    s_add_u32 s47, s47, 131072
    s_waitcnt vmcnt(9)
    ds_read_b128 v[128:131], v28 offset:0
    ds_read_b128 v[132:135], v29 offset:0
    ds_read_b128 v[136:139], v30 offset:0
    ds_read_b128 v[140:143], v31 offset:0
    ds_read_b128 v[144:147], v28 offset:16384
    ds_read_b128 v[148:151], v29 offset:16384
    ds_read_b128 v[152:155], v30 offset:16384
    ds_read_b128 v[156:159], v31 offset:16384
    buffer_load_dwordx4 v[180:183], v26, s[20:23], s47 offen nt
    s_add_u32 s47, s47, 131072
    s_waitcnt vmcnt(9)
    buffer_load_dwordx4 v[184:187], v26, s[20:23], s47 offen nt
    s_add_u32 s47, s47, 131072
    s_waitcnt vmcnt(9)
    v_perm_b32 v192, v164, v160, s62
    v_perm_b32 v196, v164, v160, s63
    v_perm_b32 v200, v165, v161, s62
    v_perm_b32 v204, v165, v161, s63
    v_perm_b32 v208, v166, v162, s62
    v_perm_b32 v212, v166, v162, s63
    v_perm_b32 v216, v167, v163, s62
    v_perm_b32 v220, v167, v163, s63
    buffer_load_dwordx4 v[188:191], v26, s[20:23], s47 offen nt
    s_waitcnt vmcnt(4)
L_chk1:
    v_xor_b32 v224, s41, v224
    v_xor_b32 v225, s41, v225
    v_xor_b32 v226, s41, v226
    v_xor_b32 v227, s41, v227
    v_xor_b32 v228, s41, v228
    v_xor_b32 v229, s41, v229
    v_xor_b32 v230, s41, v230
    v_xor_b32 v231, s41, v231
    v_xor_b32 v232, s41, v232
    v_xor_b32 v233, s41, v233
    v_xor_b32 v234, s41, v234
    v_xor_b32 v235, s41, v235
    v_xor_b32 v236, s41, v236
    v_xor_b32 v237, s41, v237
    v_xor_b32 v238, s41, v238
    v_xor_b32 v239, s41, v239
    v_pk_add_f32 v[50:51], v[224:225], v[228:229]
    v_pk_add_f32 v[54:55], v[232:233], v[236:237]
    v_pk_add_f32 v[52:53], v[226:227], v[230:231]
    v_pk_add_f32 v[56:57], v[234:235], v[238:239]
    v_pk_add_f32 v[50:51], v[50:51], v[54:55]
    v_pk_add_f32 v[52:53], v[52:53], v[56:57]
    v_cvt_pk_bf16_f32 v50, v50, v51
    v_cvt_pk_bf16_f32 v51, v52, v53
    ds_write_b64 v34, v[50:51]
    v_or3_b32 v54, v224, v225, v226
    v_or3_b32 v54, v54, v227, v228
    v_or3_b32 v54, v54, v229, v230
    v_or3_b32 v54, v54, v231, v232
    v_or3_b32 v54, v54, v233, v234
    v_or3_b32 v54, v54, v235, v236
    v_or3_b32 v54, v54, v237, v238
    v_or_b32 v54, v54, v239
    v_and_b32 v54, s42, v54
    v_cmp_ne_u32 vcc, 0, v54
    s_cbranch_vccz L_ok1
L_retry1:
    s_sub_u32 s59, s59, 1
    s_cbranch_scc1 L_end
    buffer_load_dwordx4 v[224:227], v45, s[36:39], s50 offen offset:0 sc1
    buffer_load_dwordx4 v[228:231], v45, s[36:39], s50 offen offset:512 sc1
    buffer_load_dwordx4 v[232:235], v45, s[36:39], s50 offen offset:1024 sc1
    buffer_load_dwordx4 v[236:239], v45, s[36:39], s50 offen offset:1536 sc1
    s_waitcnt vmcnt(0)
    s_branch L_chk1
L_ok1:
    s_waitcnt vmcnt(8)
    v_perm_b32 v193, v172, v168, s62
    v_perm_b32 v197, v172, v168, s63
    v_perm_b32 v201, v173, v169, s62
    v_perm_b32 v205, v173, v169, s63
    v_perm_b32 v209, v174, v170, s62
    v_perm_b32 v213, v174, v170, s63
    v_perm_b32 v217, v175, v171, s62
    v_perm_b32 v221, v175, v171, s63
    s_waitcnt lgkmcnt(0)
    s_barrier
    ds_read_b128 v[240:243], v35 offset:0
    ds_read_b128 v[244:247], v35 offset:64
    ds_read_b128 v[248:251], v35 offset:128
    ds_read_b128 v[252:255], v35 offset:192
    buffer_load_dwordx4 v[64:67], v27, s[28:31], s48 offen offset:0 nt
    s_waitcnt lgkmcnt(3)
    v_mfma_f32_16x16x32_bf16 v[224:227], v[128:131], v[240:243], 0
    v_mfma_f32_16x16x32_bf16 v[228:231], v[144:147], v[240:243], 0
    s_waitcnt lgkmcnt(2)
    v_mfma_f32_16x16x32_bf16 v[224:227], v[132:135], v[244:247], v[224:227]
    v_mfma_f32_16x16x32_bf16 v[228:231], v[148:151], v[244:247], v[228:231]
    s_waitcnt lgkmcnt(1)
    v_mfma_f32_16x16x32_bf16 v[224:227], v[136:139], v[248:251], v[224:227]
    v_mfma_f32_16x16x32_bf16 v[228:231], v[152:155], v[248:251], v[228:231]
    s_waitcnt lgkmcnt(0)
    v_mfma_f32_16x16x32_bf16 v[224:227], v[140:143], v[252:255], v[224:227]
    v_mfma_f32_16x16x32_bf16 v[228:231], v[156:159], v[252:255], v[228:231]
    buffer_load_dwordx4 v[68:71], v27, s[28:31], s48 offen offset:256 nt
    s_add_u32 s48, s48, 8192
    s_mov_b32 s60, 0x3e0293ee
    s_nop 3
    v_max3_f32 v50, v224, v225, v226
    v_max3_f32 v51, v228, v229, v230
    v_max3_f32 v50, v50, v227, v231
    v_max_f32 v50, v50, v51
    v_mov_b32 v51, v50
    s_nop 1
    v_permlane16_swap_b32 v50, v51
    v_max_f32 v50, v50, v51
    v_mov_b32 v51, v50
    s_nop 1
    v_permlane32_swap_b32 v50, v51
    v_max_f32 v50, v50, v51
    v_mul_f32 v50, s60, v50
    v_fma_f32 v224, v224, s60, -v50
    v_fma_f32 v225, v225, s60, -v50
    v_fma_f32 v226, v226, s60, -v50
    v_fma_f32 v227, v227, s60, -v50
    v_fma_f32 v228, v228, s60, -v50
    v_fma_f32 v229, v229, s60, -v50
    v_fma_f32 v230, v230, s60, -v50
    v_fma_f32 v231, v231, s60, -v50
    v_exp_f32 v224, v224
    v_exp_f32 v225, v225
    v_exp_f32 v226, v226
    v_exp_f32 v227, v227
    v_exp_f32 v228, v228
    v_exp_f32 v229, v229
    v_exp_f32 v230, v230
    v_exp_f32 v231, v231
    s_mov_b64 exec, s[64:65]
    v_cvt_pk_bf16_f32 v10, v224, v225
    v_cvt_pk_bf16_f32 v11, v226, v227
    v_cvt_pk_bf16_f32 v12, v228, v229
    v_cvt_pk_bf16_f32 v13, v230, v231
    s_not_b64 exec, s[64:65]
    v_cvt_pk_bf16_f32 v14, v224, v225
    v_cvt_pk_bf16_f32 v15, v226, v227
    v_cvt_pk_bf16_f32 v16, v228, v229
    v_cvt_pk_bf16_f32 v17, v230, v231
    s_mov_b64 exec, -1
    v_mfma_f32_16x16x32_bf16 v[128:131], v[18:21], v[10:13], 0
    v_mfma_f32_16x16x32_bf16 v[128:131], v[18:21], v[14:17], v[128:131]
    buffer_load_dwordx4 v[72:75], v27, s[28:31], s48 offen offset:0 nt
    s_mov_b64 exec, 0xff
    s_nop 5
    ds_write2_b32 v38, v50, v128 offset0:0 offset1:1
    s_mov_b64 exec, -1
    s_waitcnt vmcnt(5)
    v_perm_b32 v194, v180, v176, s62
    v_perm_b32 v198, v180, v176, s63
    v_perm_b32 v202, v181, v177, s62
    v_perm_b32 v206, v181, v177, s63
    v_perm_b32 v210, v182, v178, s62
    v_perm_b32 v214, v182, v178, s63
    v_perm_b32 v218, v183, v179, s62
    v_perm_b32 v222, v183, v179, s63
    s_waitcnt vmcnt(3)
    v_perm_b32 v195, v188, v184, s62
    v_perm_b32 v199, v188, v184, s63
    v_perm_b32 v203, v189, v185, s62
    v_perm_b32 v207, v189, v185, s63
    v_perm_b32 v211, v190, v186, s62
    v_perm_b32 v215, v190, v186, s63
    v_perm_b32 v219, v191, v187, s62
    v_perm_b32 v223, v191, v187, s63
    v_mfma_f32_16x16x32_bf16 v[160:163], v[192:195], v[10:13], 0
    v_mfma_f32_16x16x32_bf16 v[164:167], v[196:199], v[10:13], 0
    v_mfma_f32_16x16x32_bf16 v[168:171], v[200:203], v[10:13], 0
    v_mfma_f32_16x16x32_bf16 v[172:175], v[204:207], v[10:13], 0
    v_mfma_f32_16x16x32_bf16 v[160:163], v[208:211], v[14:17], v[160:163]
    buffer_load_dwordx4 v[76:79], v27, s[28:31], s48 offen offset:256 nt
    s_add_u32 s48, s48, 57344
    v_mfma_f32_16x16x32_bf16 v[164:167], v[212:215], v[14:17], v[164:167]
    v_mfma_f32_16x16x32_bf16 v[168:171], v[216:219], v[14:17], v[168:171]
    v_mfma_f32_16x16x32_bf16 v[172:175], v[220:223], v[14:17], v[172:175]
    s_nop 2
    ds_write_b128 v36, v[160:163] offset:0
    s_nop 1
    ds_write_b128 v36, v[164:167] offset:128
    ds_write_b128 v36, v[168:171] offset:256
    ds_write_b128 v36, v[172:175] offset:384
    s_waitcnt lgkmcnt(0)
    s_barrier
    ds_read_b128 v[208:211], v39
    ds_read_b128 v[212:215], v39 offset:16
    ds_read_b128 v[192:195], v37 offset:0
    ds_read_b128 v[196:199], v37 offset:4224
    ds_read_b128 v[200:203], v37 offset:8448
    ds_read_b128 v[204:207], v37 offset:12672
    buffer_load_dwordx4 v[80:83], v27, s[28:31], s48 offen offset:0 nt
    s_waitcnt lgkmcnt(4)
    v_max3_f32 v56, v208, v210, v212
    v_max_f32 v56, v56, v214
    v_bfi_b32 v56, s42, 0, v56
    v_sub_f32 v52, v208, v56
    v_sub_f32 v53, v210, v56
    v_sub_f32 v54, v212, v56
    v_sub_f32 v55, v214, v56
    v_exp_f32 v52, v52
    v_exp_f32 v53, v53
    v_exp_f32 v54, v54
    v_exp_f32 v55, v55
    v_or_b32 v56, s41, v56
    v_mul_f32 v57, v52, v209
    v_fmac_f32 v57, v53, v211
    v_fmac_f32 v57, v54, v213
    v_fmac_f32 v57, v55, v215
    s_waitcnt lgkmcnt(0)
    v_mul_f32 v192, v52, v192
    v_mul_f32 v193, v52, v193
    v_mul_f32 v194, v52, v194
    v_mul_f32 v195, v52, v195
    v_fmac_f32 v192, v53, v196
    v_fmac_f32 v193, v53, v197
    v_fmac_f32 v194, v53, v198
    v_fmac_f32 v195, v53, v199
    v_fmac_f32 v192, v54, v200
    v_fmac_f32 v193, v54, v201
    v_fmac_f32 v194, v54, v202
    v_fmac_f32 v195, v54, v203
    v_fmac_f32 v192, v55, v204
    v_fmac_f32 v193, v55, v205
    v_fmac_f32 v194, v55, v206
    v_fmac_f32 v195, v55, v207
    v_bfi_b32 v57, s42, v32, v57
    v_cvt_pk_bf16_f32 v192, v192, v193
    v_cvt_pk_bf16_f32 v193, v194, v195
    v_min_u32 v192, -2, v192
    v_min_u32 v193, -2, v193
    s_cmp_eq_u32 s69, 0
    s_cbranch_scc0 L_glob2
    buffer_store_dwordx2 v[192:193], v40, s[36:39], s51 offen
    s_mov_b32 exec_lo, 1
    s_mov_b32 exec_hi, 1
    buffer_store_dwordx2 v[56:57], v41, s[36:39], s52 offen
L_st2:
    s_mov_b64 exec, -1
    buffer_load_dwordx4 v[84:87], v27, s[28:31], s48 offen offset:256 nt
    s_add_u32 s48, s48, 8192
    s_waitcnt vmcnt(6)
    buffer_load_dwordx4 v[88:91], v27, s[28:31], s48 offen offset:0 nt
    s_waitcnt vmcnt(6)
    buffer_load_dwordx4 v[92:95], v27, s[28:31], s48 offen offset:256 nt
    s_add_u32 s48, s48, 57344
    s_waitcnt vmcnt(6)
    buffer_load_dwordx4 v[96:99], v27, s[28:31], s48 offen offset:0 nt
    s_waitcnt vmcnt(6)
    buffer_load_dwordx4 v[100:103], v27, s[28:31], s48 offen offset:256 nt
    s_add_u32 s48, s48, 8192
    s_waitcnt vmcnt(4)
    buffer_load_dwordx4 v[104:107], v27, s[28:31], s48 offen offset:0 nt
    s_waitcnt vmcnt(4)
    buffer_load_dwordx4 v[108:111], v27, s[28:31], s48 offen offset:256 nt
    s_add_u32 s48, s48, 57344
    buffer_load_dwordx4 v[136:139], v43, s[36:39], s54 offen sc1
    buffer_load_dwordx4 v[128:131], v42, s[36:39], s53 offen sc1
    buffer_load_dwordx4 v[132:135], v42, s[36:39], s66 offen sc1
    s_waitcnt vmcnt(7)
    buffer_load_dwordx4 v[112:115], v27, s[28:31], s48 offen offset:0 nt
    s_waitcnt vmcnt(7)
    buffer_load_dwordx4 v[116:119], v27, s[28:31], s48 offen offset:256 nt
    s_add_u32 s48, s48, 8192
    s_waitcnt vmcnt(7)
    buffer_load_dwordx4 v[120:123], v27, s[28:31], s48 offen offset:0 nt
    s_waitcnt vmcnt(7)
    buffer_load_dwordx4 v[124:127], v27, s[28:31], s48 offen offset:256 nt
    s_waitcnt vmcnt(4)
L_chk2:
    v_xor_b32 v136, s41, v136
    v_xor_b32 v137, s41, v137
    v_xor_b32 v138, s41, v138
    v_xor_b32 v139, s41, v139
    v_max_f32 v50, v136, v138
    v_max3_u32 v53, v128, v129, v130
    v_max3_u32 v53, v53, v131, v132
    v_max_f32_dpp v50, v50, v50 row_ror:4 row_mask:0xf bank_mask:0xf
    v_max3_u32 v53, v53, v133, v134
    v_max_u32 v53, v53, v135
    v_max_f32_dpp v50, v50, v50 row_ror:8 row_mask:0xf bank_mask:0xf
    v_or3_b32 v52, v136, v137, v138
    v_mov_b32 v51, v50
    v_or_b32 v52, v52, v139
    v_and_b32 v52, s42, v52
    v_permlane16_swap_b32 v50, v51
    v_max_f32 v50, v50, v51
    v_mov_b32 v51, v50
    v_cmp_eq_u32 vcc, -1, v53
    v_cmp_ne_u32 s[10:11], 0, v52
    v_permlane32_swap_b32 v50, v51
    v_max_f32 v50, v50, v51
    v_sub_f32 v52, v136, v50
    v_sub_f32 v53, v138, v50
    v_exp_f32 v52, v52
    v_exp_f32 v53, v53
    s_or_b64 vcc, vcc, s[10:11]
    s_cbranch_vccz L_ok2
L_retry2:
    s_sub_u32 s59, s59, 1
    s_cbranch_scc1 L_end
    buffer_load_dwordx4 v[136:139], v43, s[36:39], s54 offen sc1
    buffer_load_dwordx4 v[128:131], v42, s[36:39], s53 offen sc1
    buffer_load_dwordx4 v[132:135], v42, s[36:39], s66 offen sc1
    s_waitcnt vmcnt(0)
    s_branch L_chk2
L_ok2:
    v_cvt_pk_bf16_f32 v54, v52, v53
    v_perm_b32 v140, v132, v128, s62
    v_perm_b32 v141, v132, v128, s63
    v_perm_b32 v142, v133, v129, s62
    v_perm_b32 v143, v133, v129, s63
    v_perm_b32 v144, v134, v130, s62
    v_perm_b32 v145, v134, v130, s63
    v_perm_b32 v146, v135, v131, s62
    v_perm_b32 v147, v135, v131, s63
    v_lshlrev_b32 v52, 16, v54
    v_and_b32 v53, 0xffff0000, v54
    v_mul_f32 v51, v52, v137
    v_fmac_f32 v51, v53, v139
    v_dot2_f32_bf16 v140, v140, v54, 0
    v_dot2_f32_bf16 v141, v141, v54, 0
    v_dot2_f32_bf16 v142, v142, v54, 0
    v_dot2_f32_bf16 v143, v143, v54, 0
    v_dot2_f32_bf16 v144, v144, v54, 0
    v_dot2_f32_bf16 v145, v145, v54, 0
    v_dot2_f32_bf16 v146, v146, v54, 0
    v_dot2_f32_bf16 v147, v147, v54, 0
    v_add_f32_dpp v51, v51, v51 row_ror:4 row_mask:0xf bank_mask:0xf
    v_permlane32_swap_b32 v140, v142
    v_permlane32_swap_b32 v141, v143
    v_permlane32_swap_b32 v144, v146
    v_permlane32_swap_b32 v145, v147
    v_add_f32_dpp v51, v51, v51 row_ror:8 row_mask:0xf bank_mask:0xf
    v_add_f32 v140, v140, v142
    v_add_f32 v141, v141, v143
    v_add_f32 v144, v144, v146
    v_add_f32 v145, v145, v147
    v_mov_b32 v50, v51
    v_permlane16_swap_b32 v140, v141
    v_permlane16_swap_b32 v144, v145
    v_permlane16_swap_b32 v50, v51
    v_add_f32 v140, v140, v141
    v_add_f32 v144, v144, v145
    v_add_f32 v51, v50, v51
    v_add_f32_dpp v140, v140, v140 row_ror:4 row_mask:0xf bank_mask:0xf
    v_mov_b32 v50, v51
    v_add_f32_dpp v144, v144, v144 row_ror:4 row_mask:0xf bank_mask:0xf
    v_add_f32_dpp v140, v140, v140 row_ror:8 row_mask:0xf bank_mask:0xf
    v_permlane32_swap_b32 v50, v51
    v_add_f32 v51, v50, v51
    v_add_f32_dpp v144, v144, v144 row_ror:8 row_mask:0xf bank_mask:0xf
    v_rcp_f32 v51, v51
    s_nop 0
    v_mul_f32 v140, v140, v51
    v_mul_f32 v144, v144, v51
    v_cvt_pk_bf16_f32 v4, v140, v140
    v_cvt_pk_bf16_f32 v5, v144, v144
    s_nop 0
    v_and_b32_dpp v10, v4, v6 row_newbcast:0 row_mask:0xf bank_mask:0xf
    v_and_b32_dpp v11, v4, v7 row_newbcast:0 row_mask:0xf bank_mask:0xf
    v_and_b32_dpp v12, v4, v8 row_newbcast:0 row_mask:0xf bank_mask:0xf
    v_and_b32_dpp v13, v4, v9 row_newbcast:0 row_mask:0xf bank_mask:0xf
    s_nop 1
    v_mfma_f32_16x16x32_bf16 v[224:227], v[10:13], v[64:67], 0
    v_and_b32_dpp v14, v5, v6 row_newbcast:0 row_mask:0xf bank_mask:0xf
    v_and_b32_dpp v15, v5, v7 row_newbcast:0 row_mask:0xf bank_mask:0xf
    v_and_b32_dpp v16, v5, v8 row_newbcast:0 row_mask:0xf bank_mask:0xf
    v_and_b32_dpp v17, v5, v9 row_newbcast:0 row_mask:0xf bank_mask:0xf
    v_mfma_f32_16x16x32_bf16 v[228:231], v[10:13], v[68:71], 0
    s_nop 0
    v_mfma_f32_16x16x32_bf16 v[224:227], v[14:17], v[72:75], v[224:227]
    v_and_b32_dpp v10, v4, v6 row_newbcast:1 row_mask:0xf bank_mask:0xf
    v_and_b32_dpp v11, v4, v7 row_newbcast:1 row_mask:0xf bank_mask:0xf
    v_and_b32_dpp v12, v4, v8 row_newbcast:1 row_mask:0xf bank_mask:0xf
    v_and_b32_dpp v13, v4, v9 row_newbcast:1 row_mask:0xf bank_mask:0xf
    v_mfma_f32_16x16x32_bf16 v[228:231], v[14:17], v[76:79], v[228:231]
    s_nop 0
    v_mfma_f32_16x16x32_bf16 v[224:227], v[10:13], v[80:83], v[224:227]
    v_and_b32_dpp v14, v5, v6 row_newbcast:1 row_mask:0xf bank_mask:0xf
    v_and_b32_dpp v15, v5, v7 row_newbcast:1 row_mask:0xf bank_mask:0xf
    v_and_b32_dpp v16, v5, v8 row_newbcast:1 row_mask:0xf bank_mask:0xf
    v_and_b32_dpp v17, v5, v9 row_newbcast:1 row_mask:0xf bank_mask:0xf
    v_mfma_f32_16x16x32_bf16 v[228:231], v[10:13], v[84:87], v[228:231]
    s_nop 0
    v_mfma_f32_16x16x32_bf16 v[224:227], v[14:17], v[88:91], v[224:227]
    v_and_b32_dpp v10, v4, v6 row_newbcast:2 row_mask:0xf bank_mask:0xf
    v_and_b32_dpp v11, v4, v7 row_newbcast:2 row_mask:0xf bank_mask:0xf
    v_and_b32_dpp v12, v4, v8 row_newbcast:2 row_mask:0xf bank_mask:0xf
    v_and_b32_dpp v13, v4, v9 row_newbcast:2 row_mask:0xf bank_mask:0xf
    v_mfma_f32_16x16x32_bf16 v[228:231], v[14:17], v[92:95], v[228:231]
    s_nop 0
    v_mfma_f32_16x16x32_bf16 v[224:227], v[10:13], v[96:99], v[224:227]
    v_and_b32_dpp v14, v5, v6 row_newbcast:2 row_mask:0xf bank_mask:0xf
    v_and_b32_dpp v15, v5, v7 row_newbcast:2 row_mask:0xf bank_mask:0xf
    v_and_b32_dpp v16, v5, v8 row_newbcast:2 row_mask:0xf bank_mask:0xf
    v_and_b32_dpp v17, v5, v9 row_newbcast:2 row_mask:0xf bank_mask:0xf
    v_mfma_f32_16x16x32_bf16 v[228:231], v[10:13], v[100:103], v[228:231]
    s_nop 0
    v_mfma_f32_16x16x32_bf16 v[224:227], v[14:17], v[104:107], v[224:227]
    v_and_b32_dpp v10, v4, v6 row_newbcast:3 row_mask:0xf bank_mask:0xf
    v_and_b32_dpp v11, v4, v7 row_newbcast:3 row_mask:0xf bank_mask:0xf
    v_and_b32_dpp v12, v4, v8 row_newbcast:3 row_mask:0xf bank_mask:0xf
    v_and_b32_dpp v13, v4, v9 row_newbcast:3 row_mask:0xf bank_mask:0xf
    s_waitcnt vmcnt(7)
    v_mfma_f32_16x16x32_bf16 v[228:231], v[14:17], v[108:111], v[228:231]
    s_waitcnt vmcnt(3)
    v_mfma_f32_16x16x32_bf16 v[224:227], v[10:13], v[112:115], v[224:227]
    v_and_b32_dpp v14, v5, v6 row_newbcast:3 row_mask:0xf bank_mask:0xf
    v_and_b32_dpp v15, v5, v7 row_newbcast:3 row_mask:0xf bank_mask:0xf
    v_and_b32_dpp v16, v5, v8 row_newbcast:3 row_mask:0xf bank_mask:0xf
    v_and_b32_dpp v17, v5, v9 row_newbcast:3 row_mask:0xf bank_mask:0xf
    s_waitcnt vmcnt(2)
    v_mfma_f32_16x16x32_bf16 v[228:231], v[10:13], v[116:119], v[228:231]
    s_waitcnt vmcnt(1)
    v_mfma_f32_16x16x32_bf16 v[224:227], v[14:17], v[120:123], v[224:227]
    s_mov_b32 exec_hi, 0
    s_nop 6
    ds_write_b128 v44, v[224:227]
    s_mov_b64 exec, -1
    s_waitcnt vmcnt(0)
    v_mfma_f32_16x16x32_bf16 v[228:231], v[14:17], v[124:127], v[228:231]
    s_lshl_b32 s60, s3, 7
    s_add_u32 s60, s60, 8192
    s_lshl2_add_u32 s61, s4, s60
    v_mov_b32 v50, s43
    v_mov_b32 v51, 0
    v_and_b32 v53, 31, v1
    v_lshlrev_b32 v53, 2, v53
    s_mov_b32 exec_hi, 0
    ds_write_b128 v44, v[228:231] offset:512
    s_mov_b64 exec, 0xffff
    s_waitcnt lgkmcnt(0)
    s_barrier
    ds_read_b128 v[192:195], v61 offset:0
    ds_read_b128 v[196:199], v61 offset:1024
    ds_read_b128 v[200:203], v61 offset:2048
    ds_read_b128 v[204:207], v61 offset:3072
    s_waitcnt lgkmcnt(0)
    v_pk_add_f32 v[192:193], v[192:193], v[196:197]
    v_pk_add_f32 v[200:201], v[200:201], v[204:205]
    v_pk_add_f32 v[194:195], v[194:195], v[198:199]
    v_pk_add_f32 v[202:203], v[202:203], v[206:207]
    v_pk_add_f32 v[192:193], v[192:193], v[200:201]
    v_pk_add_f32 v[194:195], v[194:195], v[202:203]
    v_bfi_b32 v192, s42, v32, v192
    v_bfi_b32 v193, s42, v32, v193
    v_bfi_b32 v194, s42, v32, v194
    v_bfi_b32 v195, s42, v32, v195
    buffer_store_dwordx4 v[192:195], v26, s[36:39], s55 offen sc1
    s_mov_b64 exec, -1
    s_cmp_lg_u32 s40, 0
    s_cbranch_scc1 L_fin
    s_mov_b64 exec, 1
    buffer_store_dword v50, v51, s[36:39], s61 offen
    s_mov_b64 exec, -1
    s_cmp_lg_u32 s69, 0
    s_cbranch_scc1 L_nofl
L_flp:
    s_sub_u32 s59, s59, 1
    s_cbranch_scc1 L_end
    buffer_load_dword v52, v53, s[36:39], s60 offen sc1
    s_waitcnt vmcnt(0)
    v_cmp_ne_u32 vcc, s43, v52
    s_cbranch_vccnz L_flp
L_nofl:
    s_waitcnt vmcnt(0)
L_retry3:
    buffer_load_dwordx4 v[160:163], v48, s[36:39], s56 offen sc1
    s_waitcnt vmcnt(0)
    v_xor_b32 v56, s41, v160
    v_xor_b32 v57, s41, v161
    v_xor_b32 v58, s41, v162
    v_xor_b32 v59, s41, v163
    v_or3_b32 v52, v56, v57, v58
    v_or_b32 v52, v52, v59
    v_and_b32 v52, s42, v52
    v_cmp_ne_u32 vcc, 0, v52
    s_cbranch_vccz L_got3
    s_mov_b64 exec, vcc
    s_sub_u32 s59, s59, 1
    s_cbranch_scc0 L_retry3
    s_branch L_end
L_got3:
    s_mov_b64 exec, -1
    v_permlane32_swap_b32 v56, v58
    v_permlane32_swap_b32 v57, v59
    v_add_f32 v56, v56, v58
    v_add_f32 v57, v57, v59
    s_nop 1
    v_permlane16_swap_b32 v56, v57
    v_add_f32 v56, v56, v57
    s_nop 1
    v_add_f32_dpp v56, v56, v56 row_ror:2 row_mask:0xf bank_mask:0xf
    s_nop 1
    v_add_f32_dpp v56, v56, v56 row_ror:4 row_mask:0xf bank_mask:0xf
    s_nop 1
    v_add_f32_dpp v56, v56, v56 row_ror:8 row_mask:0xf bank_mask:0xf
    v_cvt_pk_bf16_f32 v56, v56, v56
    s_mov_b32 exec_lo, 0x00030003
    s_mov_b32 exec_hi, 0x00030003
    buffer_store_short v56, v46, s[32:35], s57 offen
    s_and_b32 s60, s2, 0xfb
    s_cbranch_scc1 L_fin
    s_mov_b64 exec, 1
    v_mov_b32 v50, s43
    v_mov_b32 v51, 0
    buffer_store_dword v50, v51, s[36:39], s7 offen
L_fin:
L_end:
    s_endpgm
L_helper:
    v_and_b32 v1, 63, v0
    s_and_b32 s3, s2, 7
    s_lshr_b32 s4, s2, 3
    s_and_b32 s6, s2, 3
    s_mov_b32 s38, 301993984
    s_mov_b32 s39, 0x20000
    s_lshl_b32 s7, s5, 8
    v_lshlrev_b32 v40, 4, v3
    v_lshl_add_u32 v40, v2, 13, v40
    s_lshl_b32 s51, s3, 16
    s_lshl_b32 s61, s4, 8
    s_add_u32 s51, s51, s61
    s_add_u32 s51, s51, 524288
    s_add_u32 s52, s51, 32768
    v_mov_b32 v52, -1
    v_mov_b32 v53, -1
    v_mov_b32 v54, -1
    v_mov_b32 v55, -1
    v_lshlrev_b32 v26, 4, v1
    s_waitcnt lgkmcnt(0)
    s_load_dword s43, s[36:37], s7
    buffer_store_dwordx4 v[52:55], v40, s[36:39], s51 offen
    buffer_store_dwordx4 v[52:55], v40, s[36:39], s52 offen
    s_movk_i32 s42, 1023
    s_mov_b32 s59, 8388608
    s_getreg_b32 s60, hwreg(HW_REG_XCC_ID, 0, 4)
    s_lshl_b32 s69, s60, 10
    s_lshl_b32 s68, s3, 7
    s_add_u32 s68, s68, 4096
    s_lshl2_add_u32 s67, s4, s68
    v_mov_b32 v57, 0
    v_and_b32 v47, 31, v1
    v_lshlrev_b32 v47, 2, v47
    s_waitcnt lgkmcnt(0)
    s_add_u32 s43, s43, 1
    s_and_b32 s41, s43, s42
    s_mov_b32 s42, 0xffffc3ff
    s_and_b32 s46, s43, s42
    s_or_b32 s69, s69, s46
    s_mov_b32 s46, s69
    v_mov_b32 v56, s69
    s_mov_b64 exec, 1
    buffer_store_dword v56, v57, s[36:39], s67 offen sc1
    s_mov_b64 exec, -1
    s_waitcnt vmcnt(0)
L_hpoll:
    s_sub_u32 s59, s59, 1
    s_cbranch_scc1 L_end
    buffer_load_dword v58, v47, s[36:39], s68 offen sc1
    s_waitcnt vmcnt(0)
    v_xor_b32 v58, s69, v58
    v_and_b32 v59, s42, v58
    v_cmp_ne_u32 vcc, 0, v59
    s_cbranch_vccnz L_hpoll
    v_cmp_ne_u32 vcc, 0, v58
    s_or_b32 s69, vcc_lo, vcc_hi
    s_cmp_lg_u32 s69, 0
    s_cbranch_scc1 L_hglob
L_hdone:
    v_mov_b32 v56, s69
    v_mov_b32 v57, 58368
    ds_write_b32 v57, v56
    s_waitcnt lgkmcnt(0)
    s_endpgm
L_hglob:
    buffer_store_dwordx4 v[52:55], v40, s[36:39], s51 offen sc1
    buffer_store_dwordx4 v[52:55], v40, s[36:39], s52 offen sc1
    s_waitcnt vmcnt(0)
    s_branch L_hdone
L_glob1:
    buffer_store_dwordx4 v[224:227], v26, s[36:39], s49 offen sc1
    s_branch L_st1
L_glob2:
    buffer_store_dwordx2 v[192:193], v40, s[36:39], s51 offen sc1
    s_mov_b32 exec_lo, 1
    s_mov_b32 exec_hi, 1
    buffer_store_dwordx2 v[56:57], v41, s[36:39], s52 offen sc1
    s_branch L_st2
.section .rodata,"a"
.p2align 6
.amdhsa_kernel concat_heads__sliding_block_cached__sliding_block_cached__decode_kernel
  .amdhsa_next_free_vgpr 256
  .amdhsa_next_free_sgpr 102
  .amdhsa_accum_offset 256
  .amdhsa_group_segment_fixed_size 0
  .amdhsa_kernarg_size 104
  .amdhsa_user_sgpr_count 2
  .amdhsa_user_sgpr_kernarg_segment_ptr 1
  .amdhsa_system_sgpr_workgroup_id_x 1
  .amdhsa_float_denorm_mode_32 3
.end_amdhsa_kernel
```
